```python
import torch

def _softmax(x, axis=-1):
    return torch.softmax(x, dim=axis)

def _gelu(x):
    return torch.nn.functional.gelu(x, approximate='tanh')

def _silu(x):
    return torch.nn.functional.silu(x)

def _sigmoid(x):
    return torch.sigmoid(x)

def _layernorm(x, axis=-1, eps=1e-05):
    m = x.mean(dim=axis, keepdim=True)
    v = x.var(dim=axis, keepdim=True, unbiased=False)
    return (x - m) / torch.sqrt(v + eps)

def _scatter_add(tgt, idx, src, axis=0):
    return tgt.clone().index_add_(axis, idx, src)

def _segment_sum(src, seg, n):
    out = torch.zeros((n,) + src.shape[1:], dtype=src.dtype)
    return out.index_add_(0, seg, src)

def _pad(x, pw):
    flat = tuple((v for pair in reversed(pw) for v in pair))
    return torch.nn.functional.pad(x, flat)
kernel_name = 'standalone__kv_cache_quant_pre_rope_vs_post_rope__sampling'

def setup_inputs():

    _w = lambda a: (lambda t: t.to(torch.bfloat16) if t.is_floating_point() else t)(torch.as_tensor(a))
    B, Sq, Skv = (8, 4, 8192)
    H, Dh0 = (8, 128)
    G = 64 if 64 > 0 else Dh0
    G = max(2, G // 2 * 2)
    Dh = max(G, Dh0 // G * G)
    Skv = max(Skv, Sq)
    ng = Dh // G
    bits = 8 if 8 > 1 else 4
    bits = max(2, min(8, bits))
    qmax = (1 << bits) - 1
    half = Dh // 2
    inv = 1.0 / 10000.0 ** (torch.arange(half) / max(1, half))
    ang_k = torch.arange(Skv)[:, None] * inv[None, :]
    ang_q = torch.arange(Skv - Sq, Skv)[:, None] * inv[None, :]
    kc = torch.cat([torch.cos(ang_k), torch.cos(ang_k)], dim=-1)
    ks = torch.cat([torch.sin(ang_k), torch.sin(ang_k)], dim=-1)
    qc = torch.cat([torch.cos(ang_q), torch.cos(ang_q)], dim=-1)
    qs = torch.cat([torch.sin(ang_q), torch.sin(ang_q)], dim=-1)
    qk_i = torch.randint(0, qmax + 1, (B, H, Skv, Dh)).to(torch.int32)
    qv_i = torch.randint(0, qmax + 1, (B, H, Skv, Dh)).to(torch.int32)
    ksc = torch.abs((lambda *s: torch.randn(*s, dtype=torch.bfloat16) * 0.05)(B, H, Skv, ng)) * 0.1 + 0.01
    kzp = torch.full((B, H, Skv, ng), qmax / 2.0)
    vsc = torch.abs((lambda *s: torch.randn(*s, dtype=torch.bfloat16) * 0.05)(B, H, Skv, ng)) * 0.1 + 0.01
    vzp = torch.full((B, H, Skv, ng), qmax / 2.0)
    return {'q': _w((lambda *s: torch.randn(*s, dtype=torch.bfloat16) * 0.8)(B, H, Sq, Dh) * 0.5), 'qk': _w(qk_i), 'k_scales': _w(ksc), 'k_zeros': _w(kzp), 'qv': _w(qv_i), 'v_scales': _w(vsc), 'v_zeros': _w(vzp), 'q_cos': _w(qc), 'q_sin': _w(qs), 'k_cos': _w(kc), 'k_sin': _w(ks)}

def reference(q, qk, k_scales, k_zeros, qv, v_scales, v_zeros, q_cos, q_sin, k_cos, k_sin):
    B, H, Sq, Dh = q.shape
    ng = k_scales.shape[-1]
    G = Dh // ng
    half = Dh // 2
    ks = (lambda x, n, axis: torch.repeat_interleave(x, n, dim=axis))(k_scales, G, axis=-1)
    kz = (lambda x, n, axis: torch.repeat_interleave(x, n, dim=axis))(k_zeros, G, axis=-1)
    k = ((lambda x, dt: x.to(dt))(qk, q.dtype) - kz) * ks
    vs = (lambda x, n, axis: torch.repeat_interleave(x, n, dim=axis))(v_scales, G, axis=-1)
    vz = (lambda x, n, axis: torch.repeat_interleave(x, n, dim=axis))(v_zeros, G, axis=-1)
    v = ((lambda x, dt: x.to(dt))(qv, q.dtype) - vz) * vs
    k1 = k[..., :half].clone()
    k2 = k[..., half:].clone()
    krh = torch.concatenate([-k2, k1], axis=-1)
    kr = k * k_cos[None, None, :, :] + krh * k_sin[None, None, :, :]
    q1 = q[..., :half].clone()
    q2 = q[..., half:].clone()
    qrh = torch.concatenate([-q2, q1], axis=-1)
    qr = q * q_cos[None, None, :, :] + qrh * q_sin[None, None, :, :]
    logits = torch.einsum('bhqd,bhkd->bhqk', qr, kr) * float(Dh) ** (-0.5)
    attn = _softmax(logits, axis=-1)
    out = torch.einsum('bhqk,bhkd->bhqd', attn, v)
    return out
```

```asm
; @launch grid=(512,1,1) block=(128,1,1) lds=4352
.amdgcn_target "amdgcn-amd-amdhsa--gfx950"
.text
.globl standalone__kv_cache_quant_pre_rope_vs_post_rope__sampling_kernel
.p2align 8
.type standalone__kv_cache_quant_pre_rope_vs_post_rope__sampling_kernel,@function
standalone__kv_cache_quant_pre_rope_vs_post_rope__sampling_kernel:
    s_cmp_ge_u32 s2, 512
    s_cbranch_scc1 L_end
    s_load_dwordx16 s[40:55], s[0:1], 0
    s_load_dwordx8 s[56:63], s[0:1], 64
    s_load_dwordx4 s[64:67], s[0:1], 96
    v_lshrrev_b32 v96, 6, v0
    v_and_b32 v0, 63, v0
    v_readfirstlane_b32 s68, v96
    v_and_b32 v97, 3, v0
    v_bfe_u32 v98, v0, 2, 2
    v_lshrrev_b32 v99, 4, v0
    v_lshlrev_b32 v1, 11, v98
    v_lshl_add_u32 v1, v99, 6, v1
    v_lshl_add_u32 v1, v97, 4, v1
    s_lshr_b32 s32, s2, 3
    s_and_b32 s33, s2, 7
    s_lshl_b32 s88, s32, 22
    s_lshl_b32 s89, s32, 15
    s_mul_i32 s90, s33, 2
    s_add_u32 s90, s90, s68
    s_mov_b32 s4, s90
    s_mov_b32 s71, s90
    s_lshl_b32 s69, s4, 13
    s_lshl_b32 s70, s4, 6
    s_waitcnt lgkmcnt(0)
    s_add_u32 s8, s42, s88
    s_addc_u32 s9, s43, 0
    s_mov_b32 s10, 0x400000
    s_mov_b32 s11, 0x20000
    buffer_load_dwordx4 v[8:11], v1, s[8:11], s69 offen offset:0 nt
    buffer_load_dwordx4 v[12:15], v1, s[8:11], s69 offen offset:256 nt
    buffer_load_dwordx4 v[16:19], v1, s[8:11], s69 offen offset:512 nt
    buffer_load_dwordx4 v[20:23], v1, s[8:11], s69 offen offset:768 nt
    buffer_load_dwordx4 v[24:27], v1, s[8:11], s69 offen offset:1024 nt
    buffer_load_dwordx4 v[28:31], v1, s[8:11], s69 offen offset:1280 nt
    buffer_load_dwordx4 v[32:35], v1, s[8:11], s69 offen offset:1536 nt
    buffer_load_dwordx4 v[36:39], v1, s[8:11], s69 offen offset:1792 nt
    s_add_u32 s12, s48, s88
    s_addc_u32 s13, s49, 0
    s_mov_b32 s14, 0x400000
    s_mov_b32 s15, 0x20000
    v_and_b32 v100, 15, v0
    v_lshlrev_b32 v2, 11, v99
    v_lshl_add_u32 v2, v100, 4, v2
    v_lshlrev_b32 v4, 4, v98
    v_lshlrev_b32 v5, 4, v99
    v_lshlrev_b32 v101, 8, v97
    v_lshl_add_u32 v101, v99, 5, v101
    v_lshl_add_u32 v101, v98, 3, v101
    v_lshlrev_b32 v3, 6, v99
    v_lshl_add_u32 v3, v97, 4, v3
    v_mov_b32 v158, 1
    v_mov_b32 v159, 0
    s_lshl_b32 s92, s32, 10
    s_add_u32 s40, s40, s92
    s_addc_u32 s41, s41, 0
    global_load_dwordx2 v[144:145], v101, s[40:41] offset:0 nt
    global_load_dwordx2 v[146:147], v101, s[40:41] offset:128 nt
    global_load_dwordx2 v[148:149], v101, s[54:55] offset:0 nt
    global_load_dwordx2 v[150:151], v101, s[54:55] offset:128 nt
    global_load_dwordx2 v[152:153], v101, s[56:57] offset:0 nt
    global_load_dwordx2 v[154:155], v101, s[56:57] offset:128 nt
    s_getpc_b64 s[92:93]
L_pc:
    s_add_u32 s92, s92, L_invtab-L_pc
    s_addc_u32 s93, s93, 0
    global_load_dwordx4 v[140:143], v3, s[92:93]
    s_add_u32 s16, s44, s89
    s_addc_u32 s17, s45, 0
    s_mov_b32 s18, 0x8000
    s_mov_b32 s19, 0x20000
    s_add_u32 s24, s50, s89
    s_addc_u32 s25, s51, 0
    s_mov_b32 s26, 0x8000
    s_mov_b32 s27, 0x20000
    buffer_load_dwordx4 v[72:75], v4, s[16:19], s70 offen nt
    buffer_load_dwordx4 v[80:83], v5, s[24:27], s70 offen nt
    buffer_load_dwordx4 v[40:43], v2, s[12:15], s69 offen offset:0 nt
    buffer_load_dwordx4 v[44:47], v2, s[12:15], s69 offen offset:256 nt
    buffer_load_dwordx4 v[48:51], v2, s[12:15], s69 offen offset:512 nt
    buffer_load_dwordx4 v[52:55], v2, s[12:15], s69 offen offset:768 nt
    buffer_load_dwordx4 v[56:59], v2, s[12:15], s69 offen offset:1024 nt
    buffer_load_dwordx4 v[60:63], v2, s[12:15], s69 offen offset:1280 nt
    buffer_load_dwordx4 v[64:67], v2, s[12:15], s69 offen offset:1536 nt
    buffer_load_dwordx4 v[68:71], v2, s[12:15], s69 offen offset:1792 nt
    s_mov_b32 s88, 0x7ffffff0
    buffer_load_dword v157, v159, s[8:11], s88 offen
    s_add_u32 s7, s71, 16
    s_mov_b32 s101, 4
    s_mov_b32 s6, 0
    s_mov_b32 s3, 0
    s_mov_b32 s58, 0
    s_mov_b32 s59, 0
    s_add_u32 s61, s32, s71
    s_and_b32 s61, s61, 15
    s_add_u32 s61, s61, 4
    v_lshlrev_b32 v156, 2, v98
    v_and_b32 v102, 1, v98
    v_mul_u32_u24 v102, 0x20200, v102
    v_lshlrev_b32 v102, 8, v102
    v_add_u32 v6, 0x01000c0c, v102
    v_and_b32 v102, 1, v0
    v_mul_u32_u24 v102, 0x20202, v102
    v_lshlrev_b32 v103, 8, v102
    v_and_b32 v102, 0xff, v102
    v_add_u32 v102, v102, v103
    v_add_u32 v7, 0x05040100, v102
    s_mov_b32 s72, 0x3e0293ee
    s_mov_b32 s73, 0x41000000
    s_mov_b32 s74, 0xffff0000
    s_mov_b32 s76, 0x00ff00ff
    s_mov_b32 s77, 0x00ff00ff
    s_mov_b32 s78, 0x00f000f0
    s_mov_b32 s79, 0x00f000f0
    s_mov_b32 s34, 0xc2ff0000
    s_mov_b32 s35, 0xc2ff0000
    v_mov_b32 v122, 0x42ff42ff
    v_mov_b32 v123, 0x42ff42ff
    s_mov_b32 s80, 0x3e22f983
    s_mov_b32 s81, 0x3e22f983
    s_mov_b32 s82, 0x31dc9c88
    s_mov_b32 s83, 0x31dc9c88
    s_mul_i32 s92, s32, 256
    s_add_u32 s92, s92, 0x800000
    s_add_u32 s84, s66, s92
    s_addc_u32 s85, s67, 0
    s_lshl_b32 s92, s32, 2
    s_add_u32 s86, s64, s92
    s_addc_u32 s87, s65, 0
    s_lshl_b32 s92, s32, 16
    s_add_u32 s36, s66, s92
    s_addc_u32 s37, s67, 0
    s_mov_b32 s38, 0x10000
    s_mov_b32 s39, 0x20000
    s_cmp_lg_u32 s71, 0
    s_cbranch_scc1 L_noinit
    s_mov_b64 exec, 1
    global_store_dword v159, v159, s[84:85] sc1
    global_store_dword v159, v159, s[84:85] offset:128 sc1
    s_mov_b64 exec, -1
L_noinit:
    v_lshlrev_b32 v160, 9, v97
    v_and_b32 v105, 1, v98
    v_lshl_add_u32 v160, v105, 8, v160
    v_lshl_add_u32 v160, v99, 6, v160
    s_lshl_b32 s92, s68, 11
    v_add_u32 v160, s92, v160
    s_lshl_b32 s92, s68, 5
    s_add_u32 s92, s92, 4096
    v_lshlrev_b32 v161, 3, v0
    v_add_u32 v161, s92, v161
    v_lshrrev_b32 v104, 5, v0
    s_mul_i32 s92, s68, 2
    v_add_u32 v104, s92, v104
    v_and_b32 v162, 31, v0
    v_lshlrev_b32 v162, 4, v162
    v_lshl_add_u32 v162, v104, 9, v162
    v_lshlrev_b32 v163, 3, v104
    v_add_u32 v164, 4096, v163
    v_add_u32 v163, 2048, v163
    s_lshl_b32 s92, s32, 10
    v_lshrrev_b32 v165, 1, v162
    v_add_u32 v165, s92, v165
    v_mov_b32 v166, 4160
    v_accvgpr_write_b32 a0, 0
    v_accvgpr_write_b32 a1, 0
    v_accvgpr_write_b32 a2, 0
    v_accvgpr_write_b32 a3, 0
    v_accvgpr_write_b32 a4, 0
    v_accvgpr_write_b32 a5, 0
    v_accvgpr_write_b32 a6, 0
    v_accvgpr_write_b32 a7, 0
    v_accvgpr_write_b32 a8, 0
    v_accvgpr_write_b32 a9, 0
    v_accvgpr_write_b32 a10, 0
    v_accvgpr_write_b32 a11, 0
    v_accvgpr_write_b32 a12, 0
    v_accvgpr_write_b32 a13, 0
    v_accvgpr_write_b32 a14, 0
    v_accvgpr_write_b32 a15, 0
    v_accvgpr_write_b32 a16, 0
    v_accvgpr_write_b32 a17, 0
    v_accvgpr_write_b32 a18, 0
    v_accvgpr_write_b32 a19, 0
    v_accvgpr_write_b32 a20, 0
    v_accvgpr_write_b32 a21, 0
    v_accvgpr_write_b32 a22, 0
    v_accvgpr_write_b32 a23, 0
    v_accvgpr_write_b32 a24, 0
    v_accvgpr_write_b32 a25, 0
    v_accvgpr_write_b32 a26, 0
    v_accvgpr_write_b32 a27, 0
    v_accvgpr_write_b32 a28, 0
    v_accvgpr_write_b32 a29, 0
    v_accvgpr_write_b32 a30, 0
    v_accvgpr_write_b32 a31, 0
    v_accvgpr_write_b32 a32, 0
    v_accvgpr_write_b32 a33, 0
    v_accvgpr_write_b32 a34, 0
    v_accvgpr_write_b32 a35, 0
    v_mov_b32 v124, 0xff800000
    v_mov_b32 v126, 0
    v_mov_b32 v127, 0
    s_waitcnt vmcnt(11)
    v_lshlrev_b32 v96, 16, v144
    v_and_b32 v97, s74, v144
    v_lshlrev_b32 v98, 16, v145
    v_and_b32 v99, s74, v145
    v_lshlrev_b32 v100, 16, v146
    v_and_b32 v101, s74, v146
    v_lshlrev_b32 v102, 16, v147
    v_and_b32 v103, s74, v147
    v_lshlrev_b32 v104, 16, v148
    v_and_b32 v105, s74, v148
    v_lshlrev_b32 v106, 16, v149
    v_and_b32 v107, s74, v149
    v_lshlrev_b32 v108, 16, v150
    v_and_b32 v109, s74, v150
    v_lshlrev_b32 v110, 16, v151
    v_and_b32 v111, s74, v151
    v_lshlrev_b32 v128, 16, v152
    v_and_b32 v129, s74, v152
    v_lshlrev_b32 v130, 16, v153
    v_and_b32 v131, s74, v153
    v_lshlrev_b32 v132, 16, v154
    v_and_b32 v133, s74, v154
    v_lshlrev_b32 v134, 16, v155
    v_and_b32 v135, s74, v155
    v_mul_f32 v104, v96, v104
    v_mul_f32 v108, v100, v108
    v_mul_f32 v105, v97, v105
    v_mul_f32 v109, v101, v109
    v_mul_f32 v106, v98, v106
    v_mul_f32 v110, v102, v110
    v_mul_f32 v107, v99, v107
    v_mul_f32 v111, v103, v111
    v_fma_f32 v104, -v100, v128, v104
    v_fma_f32 v108, v96, v132, v108
    v_fma_f32 v105, -v101, v129, v105
    v_fma_f32 v109, v97, v133, v109
    v_fma_f32 v106, -v102, v130, v106
    v_fma_f32 v110, v98, v134, v110
    v_fma_f32 v107, -v103, v131, v107
    v_fma_f32 v111, v99, v135, v111
    v_cvt_pk_bf16_f32 v96, v104, v105
    v_cvt_pk_bf16_f32 v97, v106, v107
    v_cvt_pk_bf16_f32 v98, v108, v109
    v_cvt_pk_bf16_f32 v99, v110, v111
    v_accvgpr_write_b32 a36, v96
    v_accvgpr_write_b32 a37, v97
    v_accvgpr_write_b32 a38, v98
    v_accvgpr_write_b32 a39, v99
    s_nop 1
L_loop:
    s_cmp_ge_u32 s4, 512
    s_cbranch_scc1 L_exit
    s_lshl_b32 s88, s4, 4
    v_add_u32 v144, s88, v156
    v_cvt_f32_u32 v144, v144
    v_add_f32 v145, 1.0, v144
    v_add_f32 v146, 2.0, v144
    v_add_f32 v147, 0x40400000, v144
    v_pk_mul_f32 v[148:149], v[140:141], v[144:145] op_sel_hi:[1,0]
    v_pk_mul_f32 v[150:151], v[142:143], v[144:145] op_sel_hi:[1,0]
    v_pk_mul_f32 v[152:153], v[148:149], s[80:81]
    v_pk_mul_f32 v[154:155], v[150:151], s[80:81]
    v_pk_fma_f32 v[104:105], v[148:149], s[80:81], v[152:153] neg_lo:[0,0,1] neg_hi:[0,0,1]
    v_pk_fma_f32 v[106:107], v[150:151], s[80:81], v[154:155] neg_lo:[0,0,1] neg_hi:[0,0,1]
    v_fract_f32 v152, v152
    v_fract_f32 v153, v153
    v_fract_f32 v154, v154
    v_fract_f32 v155, v155
    v_pk_fma_f32 v[104:105], v[148:149], s[82:83], v[104:105]
    v_pk_fma_f32 v[106:107], v[150:151], s[82:83], v[106:107]
    v_pk_add_f32 v[152:153], v[152:153], v[104:105]
    v_pk_add_f32 v[154:155], v[154:155], v[106:107]
    v_cos_f32 v148, v152
    v_cos_f32 v149, v153
    v_cos_f32 v150, v154
    v_cos_f32 v151, v155
    v_sin_f32 v104, v152
    v_sin_f32 v105, v153
    v_sin_f32 v106, v154
    v_sin_f32 v107, v155
    v_cvt_pk_bf16_f32 v152, v148, v104
    v_cvt_pk_bf16_f32 v153, v149, v105
    v_cvt_pk_bf16_f32 v154, v150, v106
    v_cvt_pk_bf16_f32 v155, v151, v107
    v_lshlrev_b32 v148, 16, v152
    v_lshlrev_b32 v149, 16, v153
    v_lshlrev_b32 v150, 16, v154
    v_lshlrev_b32 v151, 16, v155
    v_and_b32 v104, s74, v152
    v_and_b32 v105, s74, v153
    v_and_b32 v106, s74, v154
    v_and_b32 v107, s74, v155
    s_waitcnt vmcnt(9)
    v_lshlrev_b32 v88, 16, v72
    v_and_b32 v89, s74, v72
    v_cvt_f32_i32 v8, v8
    v_cvt_f32_i32 v9, v9
    v_cvt_f32_i32 v10, v10
    v_cvt_f32_i32 v11, v11
    v_pk_mul_f32 v[90:91], v[88:89], s[34:35]
    v_cvt_f32_i32 v12, v12
    v_cvt_f32_i32 v13, v13
    v_cvt_f32_i32 v14, v14
    v_cvt_f32_i32 v15, v15
    v_pk_fma_f32 v[8:9], v[8:9], v[88:89], v[90:91] op_sel_hi:[1,0,0]
    v_pk_fma_f32 v[10:11], v[10:11], v[88:89], v[90:91] op_sel_hi:[1,0,0]
    v_pk_fma_f32 v[12:13], v[12:13], v[88:89], v[90:91] op_sel:[0,1,1] op_sel_hi:[1,1,1]
    v_pk_fma_f32 v[14:15], v[14:15], v[88:89], v[90:91] op_sel:[0,1,1] op_sel_hi:[1,1,1]
    v_pk_mul_f32 v[96:97], v[8:9], v[148:149]
    v_pk_mul_f32 v[98:99], v[10:11], v[150:151]
    v_pk_mul_f32 v[100:101], v[12:13], v[148:149]
    v_pk_mul_f32 v[102:103], v[14:15], v[150:151]
    v_pk_fma_f32 v[96:97], v[12:13], v[104:105], v[96:97] neg_lo:[1,0,0] neg_hi:[1,0,0]
    v_pk_fma_f32 v[98:99], v[14:15], v[106:107], v[98:99] neg_lo:[1,0,0] neg_hi:[1,0,0]
    v_pk_fma_f32 v[100:101], v[8:9], v[104:105], v[100:101]
    v_pk_fma_f32 v[102:103], v[10:11], v[106:107], v[102:103]
    v_cvt_pk_bf16_f32 v108, v96, v97
    v_cvt_pk_bf16_f32 v109, v98, v99
    v_cvt_pk_bf16_f32 v110, v100, v101
    v_cvt_pk_bf16_f32 v111, v102, v103
    s_nop 1
    v_mfma_f32_16x16x32_bf16 v[8:11], v[108:111], a[36:39], 0
    v_lshlrev_b32 v92, 16, v73
    v_and_b32 v93, s74, v73
    v_cvt_f32_i32 v16, v16
    v_cvt_f32_i32 v17, v17
    v_cvt_f32_i32 v18, v18
    v_cvt_f32_i32 v19, v19
    v_pk_mul_f32 v[94:95], v[92:93], s[34:35]
    v_cvt_f32_i32 v20, v20
    v_cvt_f32_i32 v21, v21
    v_cvt_f32_i32 v22, v22
    v_cvt_f32_i32 v23, v23
    v_pk_mul_f32 v[148:149], v[140:141], v[144:145] op_sel:[0,1] op_sel_hi:[1,1]
    v_pk_mul_f32 v[150:151], v[142:143], v[144:145] op_sel:[0,1] op_sel_hi:[1,1]
    v_pk_mul_f32 v[152:153], v[148:149], s[80:81]
    v_pk_mul_f32 v[154:155], v[150:151], s[80:81]
    v_pk_fma_f32 v[104:105], v[148:149], s[80:81], v[152:153] neg_lo:[0,0,1] neg_hi:[0,0,1]
    v_pk_fma_f32 v[106:107], v[150:151], s[80:81], v[154:155] neg_lo:[0,0,1] neg_hi:[0,0,1]
    v_fract_f32 v152, v152
    v_fract_f32 v153, v153
    v_fract_f32 v154, v154
    v_fract_f32 v155, v155
    v_pk_fma_f32 v[104:105], v[148:149], s[82:83], v[104:105]
    v_pk_fma_f32 v[106:107], v[150:151], s[82:83], v[106:107]
    v_pk_add_f32 v[152:153], v[152:153], v[104:105]
    v_pk_add_f32 v[154:155], v[154:155], v[106:107]
    v_cos_f32 v148, v152
    v_cos_f32 v149, v153
    v_cos_f32 v150, v154
    v_cos_f32 v151, v155
    v_sin_f32 v104, v152
    v_sin_f32 v105, v153
    v_sin_f32 v106, v154
    v_sin_f32 v107, v155
    v_cvt_pk_bf16_f32 v152, v148, v104
    v_cvt_pk_bf16_f32 v153, v149, v105
    v_cvt_pk_bf16_f32 v154, v150, v106
    v_cvt_pk_bf16_f32 v155, v151, v107
    v_lshlrev_b32 v148, 16, v152
    v_lshlrev_b32 v149, 16, v153
    v_lshlrev_b32 v150, 16, v154
    v_lshlrev_b32 v151, 16, v155
    v_and_b32 v104, s74, v152
    v_and_b32 v105, s74, v153
    v_and_b32 v106, s74, v154
    v_and_b32 v107, s74, v155
    v_pk_fma_f32 v[16:17], v[16:17], v[92:93], v[94:95] op_sel_hi:[1,0,0]
    v_pk_fma_f32 v[18:19], v[18:19], v[92:93], v[94:95] op_sel_hi:[1,0,0]
    v_pk_fma_f32 v[20:21], v[20:21], v[92:93], v[94:95] op_sel:[0,1,1] op_sel_hi:[1,1,1]
    v_pk_fma_f32 v[22:23], v[22:23], v[92:93], v[94:95] op_sel:[0,1,1] op_sel_hi:[1,1,1]
    v_pk_mul_f32 v[96:97], v[16:17], v[148:149]
    v_pk_mul_f32 v[98:99], v[18:19], v[150:151]
    v_pk_mul_f32 v[100:101], v[20:21], v[148:149]
    v_pk_mul_f32 v[102:103], v[22:23], v[150:151]
    v_pk_fma_f32 v[96:97], v[20:21], v[104:105], v[96:97] neg_lo:[1,0,0] neg_hi:[1,0,0]
    v_pk_fma_f32 v[98:99], v[22:23], v[106:107], v[98:99] neg_lo:[1,0,0] neg_hi:[1,0,0]
    v_pk_fma_f32 v[100:101], v[16:17], v[104:105], v[100:101]
    v_pk_fma_f32 v[102:103], v[18:19], v[106:107], v[102:103]
    v_cvt_pk_bf16_f32 v108, v96, v97
    v_cvt_pk_bf16_f32 v109, v98, v99
    v_cvt_pk_bf16_f32 v110, v100, v101
    v_cvt_pk_bf16_f32 v111, v102, v103
    s_nop 1
    v_mfma_f32_16x16x32_bf16 v[16:19], v[108:111], a[36:39], 0
    v_lshlrev_b32 v88, 16, v74
    v_and_b32 v89, s74, v74
    v_cvt_f32_i32 v24, v24
    v_cvt_f32_i32 v25, v25
    v_cvt_f32_i32 v26, v26
    v_cvt_f32_i32 v27, v27
    v_pk_mul_f32 v[90:91], v[88:89], s[34:35]
    v_cvt_f32_i32 v28, v28
    v_cvt_f32_i32 v29, v29
    v_cvt_f32_i32 v30, v30
    v_cvt_f32_i32 v31, v31
    v_pk_mul_f32 v[148:149], v[140:141], v[146:147] op_sel_hi:[1,0]
    v_pk_mul_f32 v[150:151], v[142:143], v[146:147] op_sel_hi:[1,0]
    v_pk_mul_f32 v[152:153], v[148:149], s[80:81]
    v_pk_mul_f32 v[154:155], v[150:151], s[80:81]
    v_pk_fma_f32 v[104:105], v[148:149], s[80:81], v[152:153] neg_lo:[0,0,1] neg_hi:[0,0,1]
    v_pk_fma_f32 v[106:107], v[150:151], s[80:81], v[154:155] neg_lo:[0,0,1] neg_hi:[0,0,1]
    v_fract_f32 v152, v152
    v_fract_f32 v153, v153
    v_fract_f32 v154, v154
    v_fract_f32 v155, v155
    v_pk_fma_f32 v[104:105], v[148:149], s[82:83], v[104:105]
    v_pk_fma_f32 v[106:107], v[150:151], s[82:83], v[106:107]
    v_pk_add_f32 v[152:153], v[152:153], v[104:105]
    v_pk_add_f32 v[154:155], v[154:155], v[106:107]
    v_cos_f32 v148, v152
    v_cos_f32 v149, v153
    v_cos_f32 v150, v154
    v_cos_f32 v151, v155
    v_sin_f32 v104, v152
    v_sin_f32 v105, v153
    v_sin_f32 v106, v154
    v_sin_f32 v107, v155
    v_cvt_pk_bf16_f32 v152, v148, v104
    v_cvt_pk_bf16_f32 v153, v149, v105
    v_cvt_pk_bf16_f32 v154, v150, v106
    v_cvt_pk_bf16_f32 v155, v151, v107
    v_lshlrev_b32 v148, 16, v152
    v_lshlrev_b32 v149, 16, v153
    v_lshlrev_b32 v150, 16, v154
    v_lshlrev_b32 v151, 16, v155
    v_and_b32 v104, s74, v152
    v_and_b32 v105, s74, v153
    v_and_b32 v106, s74, v154
    v_and_b32 v107, s74, v155
    v_pk_fma_f32 v[24:25], v[24:25], v[88:89], v[90:91] op_sel_hi:[1,0,0]
    v_pk_fma_f32 v[26:27], v[26:27], v[88:89], v[90:91] op_sel_hi:[1,0,0]
    v_pk_fma_f32 v[28:29], v[28:29], v[88:89], v[90:91] op_sel:[0,1,1] op_sel_hi:[1,1,1]
    v_pk_fma_f32 v[30:31], v[30:31], v[88:89], v[90:91] op_sel:[0,1,1] op_sel_hi:[1,1,1]
    v_pk_mul_f32 v[96:97], v[24:25], v[148:149]
    v_pk_mul_f32 v[98:99], v[26:27], v[150:151]
    v_pk_mul_f32 v[100:101], v[28:29], v[148:149]
    v_pk_mul_f32 v[102:103], v[30:31], v[150:151]
    v_pk_fma_f32 v[96:97], v[28:29], v[104:105], v[96:97] neg_lo:[1,0,0] neg_hi:[1,0,0]
    v_pk_fma_f32 v[98:99], v[30:31], v[106:107], v[98:99] neg_lo:[1,0,0] neg_hi:[1,0,0]
    v_pk_fma_f32 v[100:101], v[24:25], v[104:105], v[100:101]
    v_pk_fma_f32 v[102:103], v[26:27], v[106:107], v[102:103]
    v_cvt_pk_bf16_f32 v108, v96, v97
    v_cvt_pk_bf16_f32 v109, v98, v99
    v_cvt_pk_bf16_f32 v110, v100, v101
    v_cvt_pk_bf16_f32 v111, v102, v103
    s_nop 1
    v_mfma_f32_16x16x32_bf16 v[24:27], v[108:111], a[36:39], 0
    v_lshlrev_b32 v92, 16, v75
    v_and_b32 v93, s74, v75
    v_cvt_f32_i32 v32, v32
    v_cvt_f32_i32 v33, v33
    v_cvt_f32_i32 v34, v34
    v_cvt_f32_i32 v35, v35
    v_pk_mul_f32 v[94:95], v[92:93], s[34:35]
    v_cvt_f32_i32 v36, v36
    v_cvt_f32_i32 v37, v37
    v_cvt_f32_i32 v38, v38
    v_cvt_f32_i32 v39, v39
    v_pk_mul_f32 v[148:149], v[140:141], v[146:147] op_sel:[0,1] op_sel_hi:[1,1]
    v_pk_mul_f32 v[150:151], v[142:143], v[146:147] op_sel:[0,1] op_sel_hi:[1,1]
    v_pk_mul_f32 v[152:153], v[148:149], s[80:81]
    v_pk_mul_f32 v[154:155], v[150:151], s[80:81]
    v_pk_fma_f32 v[104:105], v[148:149], s[80:81], v[152:153] neg_lo:[0,0,1] neg_hi:[0,0,1]
    v_pk_fma_f32 v[106:107], v[150:151], s[80:81], v[154:155] neg_lo:[0,0,1] neg_hi:[0,0,1]
    v_fract_f32 v152, v152
    v_fract_f32 v153, v153
    v_fract_f32 v154, v154
    v_fract_f32 v155, v155
    v_pk_fma_f32 v[104:105], v[148:149], s[82:83], v[104:105]
    v_pk_fma_f32 v[106:107], v[150:151], s[82:83], v[106:107]
    v_pk_add_f32 v[152:153], v[152:153], v[104:105]
    v_pk_add_f32 v[154:155], v[154:155], v[106:107]
    v_cos_f32 v148, v152
    v_cos_f32 v149, v153
    v_cos_f32 v150, v154
    v_cos_f32 v151, v155
    v_sin_f32 v104, v152
    v_sin_f32 v105, v153
    v_sin_f32 v106, v154
    v_sin_f32 v107, v155
    v_cvt_pk_bf16_f32 v152, v148, v104
    v_cvt_pk_bf16_f32 v153, v149, v105
    v_cvt_pk_bf16_f32 v154, v150, v106
    v_cvt_pk_bf16_f32 v155, v151, v107
    v_lshlrev_b32 v148, 16, v152
    v_lshlrev_b32 v149, 16, v153
    v_lshlrev_b32 v150, 16, v154
    v_lshlrev_b32 v151, 16, v155
    v_and_b32 v104, s74, v152
    v_and_b32 v105, s74, v153
    v_and_b32 v106, s74, v154
    v_and_b32 v107, s74, v155
    v_pk_fma_f32 v[32:33], v[32:33], v[92:93], v[94:95] op_sel_hi:[1,0,0]
    v_pk_fma_f32 v[34:35], v[34:35], v[92:93], v[94:95] op_sel_hi:[1,0,0]
    v_pk_fma_f32 v[36:37], v[36:37], v[92:93], v[94:95] op_sel:[0,1,1] op_sel_hi:[1,1,1]
    v_pk_fma_f32 v[38:39], v[38:39], v[92:93], v[94:95] op_sel:[0,1,1] op_sel_hi:[1,1,1]
    v_pk_mul_f32 v[96:97], v[32:33], v[148:149]
    v_pk_mul_f32 v[98:99], v[34:35], v[150:151]
    v_pk_mul_f32 v[100:101], v[36:37], v[148:149]
    v_pk_mul_f32 v[102:103], v[38:39], v[150:151]
    v_pk_fma_f32 v[96:97], v[36:37], v[104:105], v[96:97] neg_lo:[1,0,0] neg_hi:[1,0,0]
    v_pk_fma_f32 v[98:99], v[38:39], v[106:107], v[98:99] neg_lo:[1,0,0] neg_hi:[1,0,0]
    v_pk_fma_f32 v[100:101], v[32:33], v[104:105], v[100:101]
    v_pk_fma_f32 v[102:103], v[34:35], v[106:107], v[102:103]
    v_cvt_pk_bf16_f32 v108, v96, v97
    v_cvt_pk_bf16_f32 v109, v98, v99
    v_cvt_pk_bf16_f32 v110, v100, v101
    v_cvt_pk_bf16_f32 v111, v102, v103
    s_nop 1
    v_mfma_f32_16x16x32_bf16 v[32:35], v[108:111], a[36:39], 0
    v_perm_b32 v116, v80, v80, v6
    v_perm_b32 v117, v81, v81, v6
    v_perm_b32 v118, v82, v82, v6
    v_perm_b32 v119, v83, v83, v6
    s_waitcnt vmcnt(0)
    v_readfirstlane_b32 s100, v157
    s_add_u32 s89, s61, 1
    s_cmp_eq_u32 s6, s89
    s_cselect_b32 s57, s100, s57
    s_add_u32 s89, s100, 352
    s_add_u32 s90, s89, s101
    s_cmp_lt_u32 s58, s59
    s_cselect_b32 s89, s58, s89
    s_cselect_b32 s59, s59, s90
    s_cmp_lt_u32 s6, 21
    s_cselect_b32 s4, s7, s89
    s_cselect_b32 s59, 0, s59
    s_add_u32 s58, s4, 1
    s_add_u32 s7, s7, 16
    s_max_u32 s4, s4, s3
    s_cmp_ge_u32 s4, 512
    s_cselect_b32 s3, 512, 0
    s_lshl_b32 s69, s4, 13
    s_lshl_b32 s70, s4, 6
    buffer_load_dwordx4 v[72:75], v4, s[16:19], s70 offen nt
    buffer_load_dwordx4 v[80:83], v5, s[24:27], s70 offen nt
    v_add_f32_dpp v112, v9, v8 row_shl:4 row_mask:0xf bank_mask:0xf
    v_add_f32_dpp v113, v17, v16 row_shl:4 row_mask:0xf bank_mask:0xf
    v_add_f32_dpp v114, v25, v24 row_shl:4 row_mask:0xf bank_mask:0xf
    v_add_f32_dpp v115, v33, v32 row_shl:4 row_mask:0xf bank_mask:0xf
    v_add_f32_dpp v112, v10, v112 row_shl:8 row_mask:0xf bank_mask:0xf
    v_add_f32_dpp v113, v18, v113 row_shl:8 row_mask:0xf bank_mask:0xf
    v_add_f32_dpp v114, v26, v114 row_shl:8 row_mask:0xf bank_mask:0xf
    v_add_f32_dpp v115, v34, v115 row_shl:8 row_mask:0xf bank_mask:0xf
    v_add_f32_dpp v112, v11, v112 row_shl:12 row_mask:0xf bank_mask:0xf
    v_add_f32_dpp v113, v19, v113 row_shl:12 row_mask:0xf bank_mask:0xf
    v_add_f32_dpp v114, v27, v114 row_shl:12 row_mask:0xf bank_mask:0xf
    v_add_f32_dpp v115, v35, v115 row_shl:12 row_mask:0xf bank_mask:0xf
    buffer_load_dwordx4 v[8:11], v1, s[8:11], s69 offen offset:0 nt
    buffer_load_dwordx4 v[12:15], v1, s[8:11], s69 offen offset:256 nt
    buffer_load_dwordx4 v[16:19], v1, s[8:11], s69 offen offset:512 nt
    buffer_load_dwordx4 v[20:23], v1, s[8:11], s69 offen offset:768 nt
    buffer_load_dwordx4 v[24:27], v1, s[8:11], s69 offen offset:1024 nt
    buffer_load_dwordx4 v[28:31], v1, s[8:11], s69 offen offset:1280 nt
    buffer_load_dwordx4 v[32:35], v1, s[8:11], s69 offen offset:1536 nt
    buffer_load_dwordx4 v[36:39], v1, s[8:11], s69 offen offset:1792 nt
    v_mov_b32_dpp v112, v112 row_shr:4 row_mask:0xf bank_mask:0x2
    v_mov_b32_dpp v113, v113 row_shr:4 row_mask:0xf bank_mask:0x2
    v_mov_b32_dpp v114, v114 row_shr:4 row_mask:0xf bank_mask:0x2
    v_mov_b32_dpp v115, v115 row_shr:4 row_mask:0xf bank_mask:0x2
    v_fma_f32 v128, v112, s72, -v124
    v_fma_f32 v129, v113, s72, -v124
    v_fma_f32 v130, v114, s72, -v124
    v_fma_f32 v131, v115, s72, -v124
    v_max3_f32 v125, v128, v129, v130
    v_max_f32 v125, v125, v131
    v_cmp_nge_f32 vcc, s73, v125
    s_nop 0
    s_and_b64 vcc, vcc, s[76:77]
    s_cbranch_scc1 L_rare0
L_back0:
    v_exp_f32 v128, v128
    v_exp_f32 v129, v129
    v_exp_f32 v130, v130
    v_exp_f32 v131, v131
    v_pk_add_f32 v[126:127], v[126:127], v[128:129]
    v_pk_mul_f32 v[116:117], v[116:117], v[128:129]
    v_pk_mul_f32 v[118:119], v[118:119], v[130:131]
    v_pk_add_f32 v[126:127], v[126:127], v[130:131]
    v_cvt_pk_bf16_f32 v120, v116, v117
    v_cvt_pk_bf16_f32 v121, v118, v119
    s_nop 1
    v_mfma_f32_16x16x16_bf16 a[32:35], v[122:123], v[120:121], a[32:35]
    v_cvt_f32_i32 v40, v40
    v_cvt_f32_i32 v41, v41
    v_cvt_f32_i32 v42, v42
    v_cvt_f32_i32 v43, v43
    v_cvt_f32_i32 v48, v48
    v_cvt_f32_i32 v49, v49
    v_cvt_f32_i32 v50, v50
    v_cvt_f32_i32 v51, v51
    v_cvt_f32_i32 v56, v56
    v_cvt_f32_i32 v57, v57
    v_cvt_f32_i32 v58, v58
    v_cvt_f32_i32 v59, v59
    v_cvt_f32_i32 v64, v64
    v_cvt_f32_i32 v65, v65
    v_cvt_f32_i32 v66, v66
    v_cvt_f32_i32 v67, v67
    v_cvt_pk_bf16_f32 v96, v40, v48
    v_cvt_pk_bf16_f32 v97, v56, v64
    v_cvt_pk_bf16_f32 v98, v41, v49
    v_cvt_pk_bf16_f32 v99, v57, v65
    v_cvt_pk_bf16_f32 v100, v42, v50
    v_cvt_pk_bf16_f32 v101, v58, v66
    v_cvt_pk_bf16_f32 v102, v43, v51
    v_cvt_pk_bf16_f32 v103, v59, v67
    v_mfma_f32_16x16x16_bf16 a[0:3], v[96:97], v[120:121], a[0:3]
    v_mfma_f32_16x16x16_bf16 a[4:7], v[98:99], v[120:121], a[4:7]
    v_mfma_f32_16x16x16_bf16 a[8:11], v[100:101], v[120:121], a[8:11]
    v_mfma_f32_16x16x16_bf16 a[12:15], v[102:103], v[120:121], a[12:15]
    v_cvt_f32_i32 v44, v44
    v_cvt_f32_i32 v45, v45
    v_cvt_f32_i32 v46, v46
    v_cvt_f32_i32 v47, v47
    v_cvt_f32_i32 v52, v52
    v_cvt_f32_i32 v53, v53
    v_cvt_f32_i32 v54, v54
    v_cvt_f32_i32 v55, v55
    v_cvt_f32_i32 v60, v60
    v_cvt_f32_i32 v61, v61
    v_cvt_f32_i32 v62, v62
    v_cvt_f32_i32 v63, v63
    v_cvt_f32_i32 v68, v68
    v_cvt_f32_i32 v69, v69
    v_cvt_f32_i32 v70, v70
    v_cvt_f32_i32 v71, v71
    v_cvt_pk_bf16_f32 v104, v44, v52
    v_cvt_pk_bf16_f32 v105, v60, v68
    v_cvt_pk_bf16_f32 v106, v45, v53
    v_cvt_pk_bf16_f32 v107, v61, v69
    v_cvt_pk_bf16_f32 v108, v46, v54
    v_cvt_pk_bf16_f32 v109, v62, v70
    v_cvt_pk_bf16_f32 v110, v47, v55
    v_cvt_pk_bf16_f32 v111, v63, v71
    v_mfma_f32_16x16x16_bf16 a[16:19], v[104:105], v[120:121], a[16:19]
    v_mfma_f32_16x16x16_bf16 a[20:23], v[106:107], v[120:121], a[20:23]
    v_mfma_f32_16x16x16_bf16 a[24:27], v[108:109], v[120:121], a[24:27]
    v_mfma_f32_16x16x16_bf16 a[28:31], v[110:111], v[120:121], a[28:31]
    buffer_load_dwordx4 v[40:43], v2, s[12:15], s69 offen offset:0 nt
    buffer_load_dwordx4 v[44:47], v2, s[12:15], s69 offen offset:256 nt
    buffer_load_dwordx4 v[48:51], v2, s[12:15], s69 offen offset:512 nt
    buffer_load_dwordx4 v[52:55], v2, s[12:15], s69 offen offset:768 nt
    buffer_load_dwordx4 v[56:59], v2, s[12:15], s69 offen offset:1024 nt
    buffer_load_dwordx4 v[60:63], v2, s[12:15], s69 offen offset:1280 nt
    buffer_load_dwordx4 v[64:67], v2, s[12:15], s69 offen offset:1536 nt
    buffer_load_dwordx4 v[68:71], v2, s[12:15], s69 offen offset:1792 nt
    s_cmp_lg_u32 s3, 0
    s_cbranch_scc1 L_dummy0
    s_cmp_lt_u32 s6, 20
    s_cbranch_scc1 L_pre0
    s_cmp_eq_u32 s6, 20
    s_cbranch_scc1 L_chk0
    s_cmp_lt_u32 s58, s59
    s_cbranch_scc1 L_dummy0
    s_sub_u32 s101, 496, s4
    s_cselect_b32 s101, 0, s101
    s_lshr_b32 s101, s101, 5
    s_min_u32 s101, s101, 8
    s_max_u32 s101, s101, 1
L_atom0:
    v_mov_b32 v158, s101
    s_mov_b64 exec, 1
    global_atomic_add v157, v159, v158, s[84:85] sc0 sc1
    s_mov_b64 exec, -1
L_join0:
    s_add_u32 s6, s6, 1
    s_branch L_loop
L_exit:
    v_add_f32 v126, v126, v127
    v_accvgpr_read_b32 v88, a0
    v_accvgpr_read_b32 v92, a1
    v_accvgpr_read_b32 v96, a2
    v_accvgpr_read_b32 v100, a3
    v_mov_b32 v136, v126
    v_accvgpr_read_b32 v89, a4
    v_accvgpr_read_b32 v93, a5
    v_accvgpr_read_b32 v97, a6
    v_accvgpr_read_b32 v101, a7
    v_permlane16_swap_b32 v136, v126
    v_accvgpr_read_b32 v90, a8
    v_accvgpr_read_b32 v94, a9
    v_accvgpr_read_b32 v98, a10
    v_accvgpr_read_b32 v102, a11
    v_add_f32 v126, v126, v136
    v_accvgpr_read_b32 v91, a12
    v_accvgpr_read_b32 v95, a13
    v_mov_b32 v136, v126
    v_accvgpr_read_b32 v99, a14
    v_accvgpr_read_b32 v103, a15
    v_accvgpr_read_b32 v138, a32
    v_permlane32_swap_b32 v136, v126
    v_add_f32 v127, v126, v136
    v_mov_b32 v126, v124
    s_mov_b64 exec, s[78:79]
    v_accvgpr_read_b32 v88, a16
    v_accvgpr_read_b32 v92, a17
    v_accvgpr_read_b32 v96, a18
    v_accvgpr_read_b32 v100, a19
    v_accvgpr_read_b32 v89, a20
    v_accvgpr_read_b32 v93, a21
    v_accvgpr_read_b32 v97, a22
    v_accvgpr_read_b32 v101, a23
    v_accvgpr_read_b32 v90, a24
    v_accvgpr_read_b32 v94, a25
    v_accvgpr_read_b32 v98, a26
    v_accvgpr_read_b32 v102, a27
    v_accvgpr_read_b32 v91, a28
    v_accvgpr_read_b32 v95, a29
    v_accvgpr_read_b32 v99, a30
    v_accvgpr_read_b32 v103, a31
    v_accvgpr_read_b32 v138, a33
    s_mov_b64 exec, s[76:77]
    v_pk_add_f32 v[88:89], v[88:89], v[138:139] op_sel_hi:[1,0] neg_lo:[0,1] neg_hi:[0,1]
    v_pk_add_f32 v[90:91], v[90:91], v[138:139] op_sel_hi:[1,0] neg_lo:[0,1] neg_hi:[0,1]
    ds_write_b128 v160, v[88:91] offset:0
    v_pk_add_f32 v[92:93], v[92:93], v[138:139] op_sel_hi:[1,0] neg_lo:[0,1] neg_hi:[0,1]
    v_pk_add_f32 v[94:95], v[94:95], v[138:139] op_sel_hi:[1,0] neg_lo:[0,1] neg_hi:[0,1]
    ds_write_b128 v160, v[92:95] offset:16
    v_pk_add_f32 v[96:97], v[96:97], v[138:139] op_sel_hi:[1,0] neg_lo:[0,1] neg_hi:[0,1]
    v_pk_add_f32 v[98:99], v[98:99], v[138:139] op_sel_hi:[1,0] neg_lo:[0,1] neg_hi:[0,1]
    ds_write_b128 v160, v[96:99] offset:32
    v_pk_add_f32 v[100:101], v[100:101], v[138:139] op_sel_hi:[1,0] neg_lo:[0,1] neg_hi:[0,1]
    v_pk_add_f32 v[102:103], v[102:103], v[138:139] op_sel_hi:[1,0] neg_lo:[0,1] neg_hi:[0,1]
    ds_write_b128 v160, v[100:103] offset:48
    s_mov_b64 exec, 0xf
    ds_write_b64 v161, v[126:127]
    s_mov_b64 exec, -1
    v_mov_b32 v158, 1
    s_waitcnt lgkmcnt(0)
    s_barrier
    s_cmp_lg_u32 s68, 0
    s_cbranch_scc1 L_noatom
    s_mov_b64 exec, 1
    global_atomic_add v136, v159, v158, s[84:85] offset:128 sc0 sc1
    s_mov_b64 exec, -1
L_noatom:
    ds_read_b64 v[88:89], v164 offset:0
    ds_read_b64 v[90:91], v164 offset:32
    ds_read_b128 v[104:107], v162 offset:0
    ds_read_b128 v[108:111], v162 offset:2048
    s_waitcnt lgkmcnt(0)
    v_max_f32 v138, v88, v90
    v_sub_f32 v88, v88, v138
    v_sub_f32 v90, v90, v138
    v_exp_f32 v88, v88
    v_exp_f32 v90, v90
    v_mul_f32 v139, v88, v89
    v_pk_mul_f32 v[140:141], v[104:105], v[88:89] op_sel_hi:[1,0]
    v_pk_mul_f32 v[142:143], v[106:107], v[88:89] op_sel_hi:[1,0]
    v_fmac_f32 v139, v90, v91
    v_pk_fma_f32 v[140:141], v[108:109], v[90:91], v[140:141] op_sel_hi:[1,0,1]
    v_pk_fma_f32 v[142:143], v[110:111], v[90:91], v[142:143] op_sel_hi:[1,0,1]
    s_lshl_b32 s88, s33, 12
    buffer_store_dwordx4 v[140:143], v162, s[36:39], s88 offen sc1
    s_mov_b32 exec_lo, 0x1
    s_mov_b32 exec_hi, 0x1
    buffer_store_dwordx2 v[138:139], v163, s[36:39], s88 offen sc1
    s_mov_b64 exec, -1
    s_waitcnt vmcnt(0)
    s_cmp_lg_u32 s68, 0
    s_cbranch_scc1 L_nobc
    s_mov_b64 exec, 1
    ds_write_b32 v166, v136
    s_mov_b64 exec, -1
    s_waitcnt lgkmcnt(0)
L_nobc:
    s_barrier
    ds_read_b32 v136, v166
    s_waitcnt lgkmcnt(0)
    v_readfirstlane_b32 s88, v136
    s_nop 0
    s_and_b32 s89, s88, 0xffff
    s_cmp_eq_u32 s89, 7
    s_cbranch_scc1 L_last
    s_cmp_lg_u32 s68, 0
    s_cbranch_scc1 L_end
    s_mov_b64 exec, 1
    v_mov_b32 v158, 0x10000
    global_atomic_add v159, v158, s[84:85] offset:128 sc1
    s_mov_b64 exec, -1
    s_branch L_end
L_last:
L_poll:
    s_lshr_b32 s89, s88, 16
    s_cmp_eq_u32 s89, 7
    s_cbranch_scc1 L_go
    global_load_dword v136, v159, s[84:85] offset:128 sc1
    s_waitcnt vmcnt(0)
    v_readfirstlane_b32 s88, v136
    s_nop 1
    s_branch L_poll
L_go:
    s_add_u32 s88, s33, 1
    s_and_b32 s88, s88, 7
    s_lshl_b32 s88, s88, 12
    s_nop 0
    buffer_load_dwordx2 v[10:11], v163, s[36:39], s88 offen sc1
    buffer_load_dwordx4 v[28:31], v162, s[36:39], s88 offen sc1
    s_add_u32 s88, s33, 2
    s_and_b32 s88, s88, 7
    s_lshl_b32 s88, s88, 12
    buffer_load_dwordx2 v[12:13], v163, s[36:39], s88 offen sc1
    buffer_load_dwordx4 v[32:35], v162, s[36:39], s88 offen sc1
    s_add_u32 s88, s33, 3
    s_and_b32 s88, s88, 7
    s_lshl_b32 s88, s88, 12
    buffer_load_dwordx2 v[14:15], v163, s[36:39], s88 offen sc1
    buffer_load_dwordx4 v[36:39], v162, s[36:39], s88 offen sc1
    s_add_u32 s88, s33, 4
    s_and_b32 s88, s88, 7
    s_lshl_b32 s88, s88, 12
    buffer_load_dwordx2 v[16:17], v163, s[36:39], s88 offen sc1
    buffer_load_dwordx4 v[40:43], v162, s[36:39], s88 offen sc1
    s_add_u32 s88, s33, 5
    s_and_b32 s88, s88, 7
    s_lshl_b32 s88, s88, 12
    buffer_load_dwordx2 v[18:19], v163, s[36:39], s88 offen sc1
    buffer_load_dwordx4 v[44:47], v162, s[36:39], s88 offen sc1
    s_add_u32 s88, s33, 6
    s_and_b32 s88, s88, 7
    s_lshl_b32 s88, s88, 12
    buffer_load_dwordx2 v[20:21], v163, s[36:39], s88 offen sc1
    buffer_load_dwordx4 v[48:51], v162, s[36:39], s88 offen sc1
    s_add_u32 s88, s33, 7
    s_and_b32 s88, s88, 7
    s_lshl_b32 s88, s88, 12
    buffer_load_dwordx2 v[22:23], v163, s[36:39], s88 offen sc1
    buffer_load_dwordx4 v[52:55], v162, s[36:39], s88 offen sc1
    v_mov_b32 v8, v138
    v_mov_b32 v9, v139
    v_mov_b32 v24, v140
    v_mov_b32 v25, v141
    v_mov_b32 v26, v142
    v_mov_b32 v27, v143
    s_waitcnt vmcnt(0)
    v_max3_f32 v138, v8, v10, v12
    v_max3_f32 v138, v138, v14, v16
    v_max3_f32 v138, v138, v18, v20
    v_max_f32 v138, v138, v22
    v_sub_f32 v8, v8, v138
    v_sub_f32 v10, v10, v138
    v_sub_f32 v12, v12, v138
    v_sub_f32 v14, v14, v138
    v_sub_f32 v16, v16, v138
    v_sub_f32 v18, v18, v138
    v_sub_f32 v20, v20, v138
    v_sub_f32 v22, v22, v138
    v_exp_f32 v8, v8
    v_exp_f32 v10, v10
    v_exp_f32 v12, v12
    v_exp_f32 v14, v14
    v_exp_f32 v16, v16
    v_exp_f32 v18, v18
    v_exp_f32 v20, v20
    v_exp_f32 v22, v22
    v_mul_f32 v139, v8, v9
    v_pk_mul_f32 v[140:141], v[24:25], v[8:9] op_sel_hi:[1,0]
    v_pk_mul_f32 v[142:143], v[26:27], v[8:9] op_sel_hi:[1,0]
    v_fmac_f32 v139, v10, v11
    v_pk_fma_f32 v[140:141], v[28:29], v[10:11], v[140:141] op_sel_hi:[1,0,1]
    v_pk_fma_f32 v[142:143], v[30:31], v[10:11], v[142:143] op_sel_hi:[1,0,1]
    v_fmac_f32 v139, v12, v13
    v_pk_fma_f32 v[140:141], v[32:33], v[12:13], v[140:141] op_sel_hi:[1,0,1]
    v_pk_fma_f32 v[142:143], v[34:35], v[12:13], v[142:143] op_sel_hi:[1,0,1]
    v_fmac_f32 v139, v14, v15
    v_pk_fma_f32 v[140:141], v[36:37], v[14:15], v[140:141] op_sel_hi:[1,0,1]
    v_pk_fma_f32 v[142:143], v[38:39], v[14:15], v[142:143] op_sel_hi:[1,0,1]
    v_fmac_f32 v139, v16, v17
    v_pk_fma_f32 v[140:141], v[40:41], v[16:17], v[140:141] op_sel_hi:[1,0,1]
    v_pk_fma_f32 v[142:143], v[42:43], v[16:17], v[142:143] op_sel_hi:[1,0,1]
    v_fmac_f32 v139, v18, v19
    v_pk_fma_f32 v[140:141], v[44:45], v[18:19], v[140:141] op_sel_hi:[1,0,1]
    v_pk_fma_f32 v[142:143], v[46:47], v[18:19], v[142:143] op_sel_hi:[1,0,1]
    v_fmac_f32 v139, v20, v21
    v_pk_fma_f32 v[140:141], v[48:49], v[20:21], v[140:141] op_sel_hi:[1,0,1]
    v_pk_fma_f32 v[142:143], v[50:51], v[20:21], v[142:143] op_sel_hi:[1,0,1]
    v_fmac_f32 v139, v22, v23
    v_pk_fma_f32 v[140:141], v[52:53], v[22:23], v[140:141] op_sel_hi:[1,0,1]
    v_pk_fma_f32 v[142:143], v[54:55], v[22:23], v[142:143] op_sel_hi:[1,0,1]
    v_rcp_f32 v139, v139
    s_nop 0
    v_mul_f32 v140, v140, v139
    v_mul_f32 v141, v141, v139
    v_mul_f32 v142, v142, v139
    v_mul_f32 v143, v143, v139
    v_cvt_pk_bf16_f32 v140, v140, v141
    v_cvt_pk_bf16_f32 v141, v142, v143
    global_store_dwordx2 v165, v[140:141], s[62:63]
    s_endpgm
L_rare0:
    s_nop 1
    v_mul_f32 v132, s72, v112
    v_mul_f32 v133, s72, v113
    v_mul_f32 v134, s72, v114
    v_mul_f32 v135, s72, v115
    v_max3_f32 v125, v132, v133, v134
    v_max3_f32 v125, v125, v135, v124
    v_mov_b32 v136, v125
    s_nop 1
    v_permlane16_swap_b32 v136, v125
    v_max_f32 v125, v125, v136
    v_mov_b32 v136, v125
    s_nop 1
    v_permlane32_swap_b32 v136, v125
    v_max_f32 v125, v125, v136
    v_sub_f32 v136, v124, v125
    v_exp_f32 v136, v136
    v_mov_b32 v124, v125
    v_sub_f32 v128, v132, v124
    v_sub_f32 v129, v133, v124
    v_sub_f32 v130, v134, v124
    v_sub_f32 v131, v135, v124
    v_mul_f32 v126, v126, v136
    v_mul_f32 v127, v127, v136
    v_accvgpr_read_b32 v132, a0
    v_accvgpr_read_b32 v133, a1
    v_accvgpr_read_b32 v134, a2
    v_accvgpr_read_b32 v135, a3
    v_mul_f32 v132, v132, v136
    v_mul_f32 v133, v133, v136
    v_mul_f32 v134, v134, v136
    v_mul_f32 v135, v135, v136
    v_accvgpr_write_b32 a0, v132
    v_accvgpr_write_b32 a1, v133
    v_accvgpr_write_b32 a2, v134
    v_accvgpr_write_b32 a3, v135
    v_accvgpr_read_b32 v132, a4
    v_accvgpr_read_b32 v133, a5
    v_accvgpr_read_b32 v134, a6
    v_accvgpr_read_b32 v135, a7
    v_mul_f32 v132, v132, v136
    v_mul_f32 v133, v133, v136
    v_mul_f32 v134, v134, v136
    v_mul_f32 v135, v135, v136
    v_accvgpr_write_b32 a4, v132
    v_accvgpr_write_b32 a5, v133
    v_accvgpr_write_b32 a6, v134
    v_accvgpr_write_b32 a7, v135
    v_accvgpr_read_b32 v132, a8
    v_accvgpr_read_b32 v133, a9
    v_accvgpr_read_b32 v134, a10
    v_accvgpr_read_b32 v135, a11
    v_mul_f32 v132, v132, v136
    v_mul_f32 v133, v133, v136
    v_mul_f32 v134, v134, v136
    v_mul_f32 v135, v135, v136
    v_accvgpr_write_b32 a8, v132
    v_accvgpr_write_b32 a9, v133
    v_accvgpr_write_b32 a10, v134
    v_accvgpr_write_b32 a11, v135
    v_accvgpr_read_b32 v132, a12
    v_accvgpr_read_b32 v133, a13
    v_accvgpr_read_b32 v134, a14
    v_accvgpr_read_b32 v135, a15
    v_mul_f32 v132, v132, v136
    v_mul_f32 v133, v133, v136
    v_mul_f32 v134, v134, v136
    v_mul_f32 v135, v135, v136
    v_accvgpr_write_b32 a12, v132
    v_accvgpr_write_b32 a13, v133
    v_accvgpr_write_b32 a14, v134
    v_accvgpr_write_b32 a15, v135
    v_accvgpr_read_b32 v132, a16
    v_accvgpr_read_b32 v133, a17
    v_accvgpr_read_b32 v134, a18
    v_accvgpr_read_b32 v135, a19
    v_mul_f32 v132, v132, v136
    v_mul_f32 v133, v133, v136
    v_mul_f32 v134, v134, v136
    v_mul_f32 v135, v135, v136
    v_accvgpr_write_b32 a16, v132
    v_accvgpr_write_b32 a17, v133
    v_accvgpr_write_b32 a18, v134
    v_accvgpr_write_b32 a19, v135
    v_accvgpr_read_b32 v132, a20
    v_accvgpr_read_b32 v133, a21
    v_accvgpr_read_b32 v134, a22
    v_accvgpr_read_b32 v135, a23
    v_mul_f32 v132, v132, v136
    v_mul_f32 v133, v133, v136
    v_mul_f32 v134, v134, v136
    v_mul_f32 v135, v135, v136
    v_accvgpr_write_b32 a20, v132
    v_accvgpr_write_b32 a21, v133
    v_accvgpr_write_b32 a22, v134
    v_accvgpr_write_b32 a23, v135
    v_accvgpr_read_b32 v132, a24
    v_accvgpr_read_b32 v133, a25
    v_accvgpr_read_b32 v134, a26
    v_accvgpr_read_b32 v135, a27
    v_mul_f32 v132, v132, v136
    v_mul_f32 v133, v133, v136
    v_mul_f32 v134, v134, v136
    v_mul_f32 v135, v135, v136
    v_accvgpr_write_b32 a24, v132
    v_accvgpr_write_b32 a25, v133
    v_accvgpr_write_b32 a26, v134
    v_accvgpr_write_b32 a27, v135
    v_accvgpr_read_b32 v132, a28
    v_accvgpr_read_b32 v133, a29
    v_accvgpr_read_b32 v134, a30
    v_accvgpr_read_b32 v135, a31
    v_mul_f32 v132, v132, v136
    v_mul_f32 v133, v133, v136
    v_mul_f32 v134, v134, v136
    v_mul_f32 v135, v135, v136
    v_accvgpr_write_b32 a28, v132
    v_accvgpr_write_b32 a29, v133
    v_accvgpr_write_b32 a30, v134
    v_accvgpr_write_b32 a31, v135
    v_accvgpr_read_b32 v132, a32
    v_accvgpr_read_b32 v133, a33
    v_accvgpr_read_b32 v134, a34
    v_accvgpr_read_b32 v135, a35
    v_mul_f32 v132, v132, v136
    v_mul_f32 v133, v133, v136
    v_mul_f32 v134, v134, v136
    v_mul_f32 v135, v135, v136
    v_accvgpr_write_b32 a32, v132
    v_accvgpr_write_b32 a33, v133
    v_accvgpr_write_b32 a34, v134
    v_accvgpr_write_b32 a35, v135
    s_nop 1
    s_branch L_back0
L_pre0:
    s_cmp_eq_u32 s6, s61
    s_cbranch_scc1 L_flag0
    s_or_b32 s88, s6, s71
    s_cbranch_scc1 L_dummy0
    s_waitcnt vmcnt(0)
    s_mov_b64 exec, 1
    v_mov_b32 v136, 0x100
    global_atomic_add v159, v136, s[86:87] sc1
    s_mov_b64 exec, -1
L_dummy0:
    s_mov_b32 s88, 0x7ffffff0
    buffer_load_dword v157, v159, s[8:11], s88 offen
    s_branch L_join0
L_flag0:
    global_load_dword v157, v159, s[86:87] sc1
    s_branch L_join0
L_chk0:
    s_mov_b32 s100, s57
L_spin0:
    s_and_b32 s88, s100, 0xff00
    s_cbranch_scc1 L_atom0
    global_load_dword v157, v159, s[86:87] sc1
    s_waitcnt vmcnt(0)
    v_readfirstlane_b32 s100, v157
    s_nop 1
    s_branch L_spin0
L_end:
    s_endpgm
.p2align 6
.type L_invtab,@object
L_invtab:
    .long 0x3f800000, 0x3f5dafd7, 0x3f3ff911, 0x3f263de0, 0x3f0ff59a, 0x3ef953cf, 0x3ed7e89b, 0x3ebaf81b
    .long 0x3ea1e89b, 0x3e8c3504, 0x3e72d423, 0x3e5247ed, 0x3e361887, 0x3e1db040, 0x3e088d77, 0x3dec7fd6
    .long 0x3dcccccd, 0x3db15978, 0x3d99940d, 0x3d84fe4d, 0x3d6655c2, 0x3d47763f, 0x3d2cba15, 0x3d159348
    .long 0x3d0186e3, 0x3ce054d2, 0x3cc2434f, 0x3ca8398b, 0x3c91ad39, 0x3c7c4d33, 0x3c5a7bf2, 0x3c3d3311
    .long 0x3c23d70a, 0x3c0de12d, 0x3bf5b9b0, 0x3bd4ca15, 0x3bb8449c, 0x3b9f91cc, 0x3b8a2e77, 0x3b6f520e
    .long 0x3b4f3e38, 0x3b33770f, 0x3b1b690d, 0x3b06946f, 0x3ae91528, 0x3ac9d75c, 0x3aaec98e, 0x3a975c0e
    .long 0x3a83126f, 0x3a6301e2, 0x3a44948c, 0x3a2a3b44, 0x3a136a16, 0x39ff4fac, 0x39dd1725, 0x39bf74d7
    .long 0x39a5cb60, 0x398f9272, 0x3978a815, 0x395753e4, 0x393a7753, 0x39217916, 0x390bd472, 0x38f22ce2
.size L_invtab, 256
.section .rodata,"a"
.p2align 6
.amdhsa_kernel standalone__kv_cache_quant_pre_rope_vs_post_rope__sampling_kernel
  .amdhsa_next_free_vgpr 264
  .amdhsa_next_free_sgpr 102
  .amdhsa_accum_offset 168
  .amdhsa_group_segment_fixed_size 0
  .amdhsa_kernarg_size 112
  .amdhsa_user_sgpr_count 2
  .amdhsa_user_sgpr_kernarg_segment_ptr 1
  .amdhsa_system_sgpr_workgroup_id_x 1
  .amdhsa_float_denorm_mode_32 3
.end_amdhsa_kernel
```
